```python
import torch

def _softmax(x, axis=-1):
    return torch.softmax(x, dim=axis)

def _gelu(x):
    return torch.nn.functional.gelu(x, approximate='tanh')

def _silu(x):
    return torch.nn.functional.silu(x)

def _sigmoid(x):
    return torch.sigmoid(x)

def _layernorm(x, axis=-1, eps=1e-05):
    m = x.mean(dim=axis, keepdim=True)
    v = x.var(dim=axis, keepdim=True, unbiased=False)
    return (x - m) / torch.sqrt(v + eps)

def _scatter_add(tgt, idx, src, axis=0):
    return tgt.clone().index_add_(axis, idx, src)

def _segment_sum(src, seg, n):
    out = torch.zeros((n,) + src.shape[1:], dtype=src.dtype)
    return out.index_add_(0, seg, src)

def _pad(x, pw):
    flat = tuple((v for pair in reversed(pw) for v in pair))
    return torch.nn.functional.pad(x, flat)
kernel_name = 'standalone__tree_speculative_verify_tree_attention_over_candidate_token_tree__decode'

def setup_inputs():

    _w = lambda a: (lambda t: t.to(torch.bfloat16) if t.is_floating_point() else t)(torch.as_tensor(a))
    B, Hq, Hkv, T, C, D = (2, 32, 32, 1, 16384, 128)
    tree_mask = torch.zeros((B, T, T), dtype=float)
    for b in range(B):
        parent = torch.zeros(T, dtype=torch.int64)
        for i in range(1, T):
            parent[i] = int(torch.randint(0, i, (1,)).item())
        for i in range(T):
            j = i
            tree_mask[b, i, j] = 1.0
            while j > 0:
                j = parent[j]
                tree_mask[b, i, j] = 1.0
    return {'q': _w((lambda *s: torch.randn(*s, dtype=torch.bfloat16) * 0.8)(B, Hq, T, D)), 'k_cache': _w((lambda *s: torch.randn(*s, dtype=torch.bfloat16) * 0.8)(B, Hkv, C, D)), 'v_cache': _w((lambda *s: torch.randn(*s, dtype=torch.bfloat16) * 0.05)(B, Hkv, C, D)), 'k_tree': _w((lambda *s: torch.randn(*s, dtype=torch.bfloat16) * 0.8)(B, Hkv, T, D)), 'v_tree': _w((lambda *s: torch.randn(*s, dtype=torch.bfloat16) * 0.05)(B, Hkv, T, D)), 'tree_mask': _w(tree_mask)}

def reference(q, k_cache, v_cache, k_tree, v_tree, tree_mask):
    B, Hq, T, D = q.shape
    Hkv, C = (k_cache.shape[1], k_cache.shape[2])
    rep = Hq // Hkv
    kc = (lambda x, n, axis: torch.repeat_interleave(x, n, dim=axis))(k_cache, rep, axis=1)
    vc = (lambda x, n, axis: torch.repeat_interleave(x, n, dim=axis))(v_cache, rep, axis=1)
    kt = (lambda x, n, axis: torch.repeat_interleave(x, n, dim=axis))(k_tree, rep, axis=1)
    vt = (lambda x, n, axis: torch.repeat_interleave(x, n, dim=axis))(v_tree, rep, axis=1)
    k = torch.concatenate([kc, kt], axis=2)
    v = torch.concatenate([vc, vt], axis=2)
    scale = D ** (-0.5)
    scores = torch.einsum('bhqd,bhkd->bhqk', q, k) * scale
    ctx_mask = torch.ones((B, 1, T, C), dtype=scores.dtype)
    tm = tree_mask[:, None, :, :].clone()
    full_mask = torch.concatenate([ctx_mask, tm], axis=-1)
    scores = scores + (1.0 - full_mask) * -1000000000.0
    p = _softmax(scores, axis=-1)
    return torch.einsum('bhqk,bhkd->bhqd', p, v)
```

```asm
; @launch grid=(256,1,1) block=(256,1,1) lds=20480
.amdgcn_target "amdgcn-amd-amdhsa--gfx950"

.text
.globl standalone__tree_speculative_verify_tree_attention_over_candidate_token_tree__decode_kernel
.p2align 8
.type standalone__tree_speculative_verify_tree_attention_over_candidate_token_tree__decode_kernel,@function
standalone__tree_speculative_verify_tree_attention_over_candidate_token_tree__decode_kernel:
    s_load_dwordx16 s[4:19], s[0:1], 0
    s_load_dwordx2 s[20:21], s[0:1], 64
    s_cmp_ge_u32 s2, 256
    s_cbranch_scc1 L_end
    s_getpc_b64 s[60:61]
L_pf:
    s_and_b32 s3, s2, 0xf8
    v_and_b32 v28, 0xc0, v0
    v_lshl_add_u32 v28, s3, 5, v28
    v_min_u32 v28, L_last-L_pf, v28
    v_mov_b32 v29, 0
    v_lshl_add_u64 v[28:29], v[28:29], 0, s[60:61]
    global_load_dword v47, v[28:29], off
    s_bfe_u32 s22, s2, 65543
    s_bfe_u32 s23, s2, 196611
    s_and_b32 s3, s23, 6
    s_add_u32 s23, s23, s3
    s_and_b32 s3, s2, 1
    s_lshl1_add_u32 s23, s3, s23
    s_and_b32 s3, s2, 6
    s_lshl3_add_u32 s32, s3, s23
    s_lshl1_add_u32 s22, s32, s22
    s_lshl_b32 s22, s22, 21
    s_lshr_b32 s3, s2, 1
    s_xor_b32 s3, s3, s2
    s_and_b32 s3, s3, 4
    s_and_b32 s23, s2, 64
    s_lshl3_add_u32 s3, s3, s23
    s_lshl_b32 s63, s3, 9
    s_or_b32 s34, s63, 524288
    s_mov_b32 s26, 2097152
    s_mov_b32 s27, 0x20000
    v_and_b32 v1, 63, v0
    v_and_b32 v23, 64, v0
    v_lshl_or_b32 v1, v23, 10, v1
    v_and_b32 v23, 0x80, v0
    v_lshl_or_b32 v1, v23, 2, v1
    v_lshlrev_b32 v1, 4, v1
    v_and_b32 v23, 0xf0, v1
    v_lshl_or_b32 v23, s32, 8, v23
    s_waitcnt lgkmcnt(0)
    s_add_u32 s24, s6, s22
    s_addc_u32 s25, s7, 0
    global_load_dwordx4 v[2:5], v23, s[4:5] nt
    buffer_load_dwordx4 v[60:63], v1, s[24:27], s63 offen offset:0 nt
    buffer_load_dwordx4 v[64:67], v1, s[24:27], s63 offen offset:1024 nt
    buffer_load_dwordx4 v[68:71], v1, s[24:27], s63 offen offset:2048 nt
    buffer_load_dwordx4 v[72:75], v1, s[24:27], s63 offen offset:3072 nt
    buffer_load_dwordx4 v[76:79], v1, s[24:27], s34 offen offset:0 nt
    buffer_load_dwordx4 v[80:83], v1, s[24:27], s34 offen offset:1024 nt
    v_lshrrev_b32 v7, 6, v0
    s_add_u32 s28, s8, s22
    s_addc_u32 s29, s9, 0
    s_load_dword s45, s[28:29], 0
    v_readfirstlane_b32 s38, v7
    s_mov_b32 s39, 0
    s_mov_b32 s73, 0
    s_bfe_u32 s33, s2, 131078
    s_xor_b32 s33, s33, 3
    s_mov_b32 s64, 0
    s_mov_b64 vcc, 0
    s_getreg_b32 s23, hwreg(HW_REG_XCC_ID, 0, 1)
    s_cmp_lg_u32 s23, 0
    s_cselect_b32 s78, 0, 8
    s_mov_b32 s36, 0x3e0293ee
    s_mov_b32 s37, 0xffff0000
    s_mov_b32 s56, 0xaaaaaaaa
    s_mov_b32 s57, 0xaaaaaaaa
    s_mov_b32 s58, 0xcccccccc
    s_mov_b32 s59, 0xcccccccc
    v_mov_b32 v6, 0xff7fffff
    v_and_b32 v46, 63, v0
    v_lshlrev_b32 v45, 2, v46
    v_lshl_add_u32 v45, v7, 12, v45
    s_lshr_b32 s72, s2, 3
    v_mov_b32 v51, 0
    v_mov_b32 v48, 1
    v_lshlrev_b32 v52, 2, v46
    v_lshrrev_b32 v49, 4, v46
    v_mul_u32_u24 v49, 160, v49
    v_writelane_b32 v46, 64, s72
    v_lshlrev_b32 v53, 4, v0
    s_lshl2_add_u32 s22, s32, s33
    s_lshl_b32 s22, s22, 10
    v_add_u32 v54, s22, v53
    v_add_u32 v55, 262144, v54
    v_bfe_u32 v56, v0, 4, 2
    v_lshl_add_u32 v56, v56, 2, v23
    s_and_b32 s3, s2, 7
    s_mul_i32 s3, s3, 4352
    s_add_u32 s3, s3, 524288
    s_mov_b32 s70, 128
    s_mov_b32 s71, 0x20000
    s_lshl_b32 s30, s38, 8
    s_add_u32 s22, s22, s30
    s_add_u32 s68, s20, s3
    s_addc_u32 s69, s21, 0
    s_cmp_lg_u32 s38, 0
    s_cbranch_scc1 L_noreset
    s_mov_b64 exec, 0x1ffff
    buffer_store_dword v49, v52, s[68:71], 0 offen
    s_mov_b64 exec, -1
L_noreset:
    s_and_b32 s3, s38, 1
    s_lshl_b32 s3, s3, 6
    s_load_dword s44, s[68:69], s3
    s_add_u32 s30, s20, s22
    s_addc_u32 s31, s21, 0
    s_cmp_eq_u32 s33, 0
    s_cselect_b32 s30, s68, s30
    s_cselect_b32 s31, s69, s31
    s_cselect_b32 s35, 0, 0xfc
    s_cmp_eq_u32 s38, 1
    s_cselect_b32 s40, s72, -2
    s_bitcmp1_b32 0x15555554, s72
    s_cselect_b32 s40, s40, -2
    s_add_u32 s41, s40, 1
    s_mul_i32 s50, s72, 4480
    s_add_u32 s50, s50, 786432
    s_or_b32 s77, s33, s38
    s_cbranch_scc1 L_notree
    s_lshr_b32 s23, s32, 5
    s_lshl_b32 s23, s23, 1
    v_mov_b32 v44, s23
    global_load_dwordx4 v[36:39], v23, s[10:11] nt
    global_load_dwordx4 v[40:43], v23, s[12:13] nt
    global_load_ushort v44, v44, s[14:15] nt
L_notree:
    s_lshl2_add_u32 s3, s2, s38
    s_cmp_eq_u32 s3, 33
    s_cbranch_scc1 L_mktag
L_loopK:
    s_cbranch_vccz L_loK0
    s_waitcnt vmcnt(3)
L_loK0:
    s_bitcmp1_b32 s64, 6
    s_cbranch_scc0 L_goK0
    s_waitcnt vmcnt(4)
L_goK0:
    s_waitcnt vmcnt(5)
    buffer_load_dwordx4 v[84:87], v1, s[24:27], s34 offen offset:2048 nt
    v_dot2_f32_bf16 v16, v60, v2, 0
    v_dot2_f32_bf16 v16, v61, v3, v16
    v_dot2_f32_bf16 v16, v62, v4, v16
    v_dot2_f32_bf16 v16, v63, v5, v16
    s_bitcmp1_b32 s64, 7
    s_cbranch_scc0 L_goK1
    s_waitcnt vmcnt(4)
L_goK1:
    s_waitcnt vmcnt(5)
    buffer_load_dwordx4 v[88:91], v1, s[24:27], s34 offen offset:3072 nt
    v_dot2_f32_bf16 v20, v64, v2, 0
    v_dot2_f32_bf16 v20, v65, v3, v20
    v_dot2_f32_bf16 v20, v66, v4, v20
    v_dot2_f32_bf16 v20, v67, v5, v20
    v_add_f32_dpp v16, v16, v16 row_ror:8 row_mask:0xf bank_mask:0x3
    s_or_b32 s34, s63, 65536
    s_bitcmp1_b32 s64, 8
    s_cbranch_scc0 L_goK2
    s_waitcnt vmcnt(4)
L_goK2:
    s_waitcnt vmcnt(5)
    buffer_load_dwordx4 v[92:95], v1, s[24:27], s34 offen offset:0 nt
    s_cmp_eq_u32 s41, s73
    s_cbranch_scc1 L_glKb
L_glrKb:
    v_dot2_f32_bf16 v21, v68, v2, 0
    v_dot2_f32_bf16 v21, v69, v3, v21
    v_dot2_f32_bf16 v21, v70, v4, v21
    v_dot2_f32_bf16 v21, v71, v5, v21
    v_add_f32_dpp v16, v20, v20 row_ror:8 row_mask:0xf bank_mask:0xc
    s_cbranch_vccz L_loK3
    s_waitcnt vmcnt(3)
L_loK3:
    s_bitcmp1_b32 s64, 9
    s_cbranch_scc0 L_goK3
    s_waitcnt vmcnt(4)
L_goK3:
    s_waitcnt vmcnt(5)
    buffer_load_dwordx4 v[96:99], v1, s[24:27], s34 offen offset:1024 nt
    v_dot2_f32_bf16 v22, v72, v2, 0
    v_dot2_f32_bf16 v22, v73, v3, v22
    v_dot2_f32_bf16 v22, v74, v4, v22
    v_dot2_f32_bf16 v22, v75, v5, v22
    v_add_f32_dpp v21, v21, v21 row_ror:8 row_mask:0xf bank_mask:0x3
    v_add_f32_dpp v16, v16, v16 row_shl:4 row_mask:0xf bank_mask:0x5
    s_nop 0
    v_add_f32_dpp v21, v22, v22 row_ror:8 row_mask:0xf bank_mask:0xc
    s_nop 1
    v_add_f32_dpp v16, v21, v21 row_shr:4 row_mask:0xf bank_mask:0xa
    s_nop 1
    v_add_f32_dpp v16, v16, v16 quad_perm:[1,0,3,2] row_mask:0xf bank_mask:0xf
    s_bitcmp1_b32 s64, 10
    s_cbranch_scc0 L_goK4
    s_waitcnt vmcnt(4)
L_goK4:
    s_waitcnt vmcnt(5)
    buffer_store_byte v48, off, s[68:71], s72 offset:0
    buffer_load_dwordx4 v[100:103], v1, s[24:27], s34 offen offset:2048 nt
    v_dot2_f32_bf16 v17, v76, v2, 0
    v_dot2_f32_bf16 v17, v77, v3, v17
    v_dot2_f32_bf16 v17, v78, v4, v17
    v_dot2_f32_bf16 v17, v79, v5, v17
    s_bitcmp1_b32 s64, 11
    s_cbranch_scc0 L_goK5
    s_waitcnt vmcnt(5)
L_goK5:
    s_waitcnt vmcnt(6)
    buffer_load_dwordx4 v[104:107], v1, s[24:27], s34 offen offset:3072 nt
    v_dot2_f32_bf16 v20, v80, v2, 0
    v_dot2_f32_bf16 v20, v81, v3, v20
    v_dot2_f32_bf16 v20, v82, v4, v20
    v_dot2_f32_bf16 v20, v83, v5, v20
    v_add_f32_dpp v17, v17, v17 row_ror:8 row_mask:0xf bank_mask:0x3
    s_or_b32 s34, s63, 589824
    s_cbranch_vccz L_loK6
    s_waitcnt vmcnt(4)
L_loK6:
    s_bitcmp1_b32 s64, 12
    s_cbranch_scc0 L_goK6
    s_waitcnt vmcnt(5)
L_goK6:
    s_waitcnt vmcnt(6)
    buffer_load_ubyte v47, v46, s[68:71], 0 offen
    buffer_load_dwordx4 v[108:111], v1, s[24:27], s34 offen offset:0 nt
    v_dot2_f32_bf16 v21, v84, v2, 0
    v_dot2_f32_bf16 v21, v85, v3, v21
    v_dot2_f32_bf16 v21, v86, v4, v21
    v_dot2_f32_bf16 v21, v87, v5, v21
    v_add_f32_dpp v17, v20, v20 row_ror:8 row_mask:0xf bank_mask:0xc
    s_bitcmp1_b32 s64, 13
    s_cbranch_scc0 L_goK7
    s_waitcnt vmcnt(6)
L_goK7:
    s_waitcnt vmcnt(7)
    buffer_load_dwordx4 v[112:115], v1, s[24:27], s34 offen offset:1024 nt
    v_dot2_f32_bf16 v22, v88, v2, 0
    v_dot2_f32_bf16 v22, v89, v3, v22
    v_dot2_f32_bf16 v22, v90, v4, v22
    v_dot2_f32_bf16 v22, v91, v5, v22
    v_add_f32_dpp v21, v21, v21 row_ror:8 row_mask:0xf bank_mask:0x3
    v_add_f32_dpp v17, v17, v17 row_shl:4 row_mask:0xf bank_mask:0x5
    s_nop 0
    v_add_f32_dpp v21, v22, v22 row_ror:8 row_mask:0xf bank_mask:0xc
    s_nop 1
    v_add_f32_dpp v17, v21, v21 row_shr:4 row_mask:0xf bank_mask:0xa
    s_nop 1
    v_add_f32_dpp v17, v17, v17 quad_perm:[1,0,3,2] row_mask:0xf bank_mask:0xf
    s_bitcmp1_b32 s64, 14
    s_cbranch_scc0 L_goK8
    s_waitcnt vmcnt(6)
L_goK8:
    s_waitcnt vmcnt(7)
    buffer_store_byte v48, off, s[68:71], s72 offset:32
    buffer_load_dwordx4 v[116:119], v1, s[24:27], s34 offen offset:2048 nt
    s_cmp_eq_u32 s40, s73
    s_cbranch_scc1 L_glKa
L_glrKa:
    v_dot2_f32_bf16 v18, v92, v2, 0
    v_dot2_f32_bf16 v18, v93, v3, v18
    v_dot2_f32_bf16 v18, v94, v4, v18
    v_dot2_f32_bf16 v18, v95, v5, v18
    v_cndmask_b32 v16, v16, v17, s[56:57]
    s_bitcmp1_b32 s64, 15
    s_cbranch_scc0 L_goK9
    s_waitcnt vmcnt(6)
L_goK9:
    s_waitcnt vmcnt(8)
    buffer_load_dwordx4 v[120:123], v1, s[24:27], s34 offen offset:3072 nt
    v_dot2_f32_bf16 v20, v96, v2, 0
    v_dot2_f32_bf16 v20, v97, v3, v20
    v_dot2_f32_bf16 v20, v98, v4, v20
    v_dot2_f32_bf16 v20, v99, v5, v20
    v_add_f32_dpp v18, v18, v18 row_ror:8 row_mask:0xf bank_mask:0x3
    v_add_f32_dpp v16, v16, v16 quad_perm:[2,3,0,1] row_mask:0xf bank_mask:0xf
    s_add_u32 s39, s39, 1
    s_ff1_i32_b32 s3, s39
    s_min_u32 s3, s3, 3
    s_lshl_b32 s3, s3, 3
    s_lshr_b32 s3, 0x0c0e1211, s3
    s_lshl_b32 s3, 1, s3
    s_xor_b32 s63, s63, s3
    s_and_b32 s39, s39, 15
    s_cselect_b32 s24, s24, s28
    s_cselect_b32 s25, s25, s29
    s_cbranch_vccz L_loK10
    s_waitcnt vmcnt(4)
L_loK10:
    s_bitcmp1_b32 s64, 0
    s_cbranch_scc0 L_goK10
    s_waitcnt vmcnt(6)
L_goK10:
    s_waitcnt vmcnt(7)
    buffer_load_dwordx4 v[60:63], v1, s[24:27], s63 offen offset:0 nt
    v_dot2_f32_bf16 v21, v100, v2, 0
    v_dot2_f32_bf16 v21, v101, v3, v21
    v_dot2_f32_bf16 v21, v102, v4, v21
    v_dot2_f32_bf16 v21, v103, v5, v21
    v_add_f32_dpp v18, v20, v20 row_ror:8 row_mask:0xf bank_mask:0xc
    s_bitcmp1_b32 s64, 1
    s_cbranch_scc0 L_goK11
    s_waitcnt vmcnt(5)
L_goK11:
    s_waitcnt vmcnt(7)
    buffer_load_dwordx4 v[64:67], v1, s[24:27], s63 offen offset:1024 nt
    v_dot2_f32_bf16 v22, v104, v2, 0
    v_dot2_f32_bf16 v22, v105, v3, v22
    v_dot2_f32_bf16 v22, v106, v4, v22
    v_dot2_f32_bf16 v22, v107, v5, v22
    v_add_f32_dpp v21, v21, v21 row_ror:8 row_mask:0xf bank_mask:0x3
    v_add_f32_dpp v18, v18, v18 row_shl:4 row_mask:0xf bank_mask:0x5
    s_nop 0
    v_add_f32_dpp v21, v22, v22 row_ror:8 row_mask:0xf bank_mask:0xc
    s_nop 1
    v_add_f32_dpp v18, v21, v21 row_shr:4 row_mask:0xf bank_mask:0xa
    s_nop 1
    v_add_f32_dpp v18, v18, v18 quad_perm:[1,0,3,2] row_mask:0xf bank_mask:0xf
    s_bitcmp1_b32 s64, 2
    s_cbranch_scc0 L_goK12
    s_waitcnt vmcnt(5)
L_goK12:
    s_waitcnt vmcnt(6)
    buffer_load_dwordx4 v[68:71], v1, s[24:27], s63 offen offset:2048 nt
    v_cmp_ge_u32 s[74:75], v47, v48
    v_readlane_b32 s43, v47, s72
    v_add_u32 v48, 1, v48
    s_add_u32 s73, s73, 1
    s_bcnt1_i32_b64 s66, s[74:75]
    s_add_u32 s66, s66, s78
    s_add_u32 s66, s66, s43
    s_cmp_ge_u32 s66, 202
    s_cselect_b32 s64, 0x7777, -1
    s_cmp_ge_u32 s66, 214
    s_cselect_b32 s64, 0, s64
    s_cmp_lt_u32 s66, 180
    s_cselect_b64 vcc, -1, 0
    v_dot2_f32_bf16 v19, v108, v2, 0
    v_dot2_f32_bf16 v19, v109, v3, v19
    v_dot2_f32_bf16 v19, v110, v4, v19
    v_dot2_f32_bf16 v19, v111, v5, v19
    s_cbranch_vccz L_loK13
    s_waitcnt vmcnt(3)
L_loK13:
    s_bitcmp1_b32 s64, 3
    s_cbranch_scc0 L_goK13
    s_waitcnt vmcnt(4)
L_goK13:
    s_waitcnt vmcnt(6)
    buffer_load_dwordx4 v[72:75], v1, s[24:27], s63 offen offset:3072 nt
    s_cmp_eq_u32 s41, s73
    s_cbranch_scc1 L_glKc
L_glrKc:
    v_dot2_f32_bf16 v20, v112, v2, 0
    v_dot2_f32_bf16 v20, v113, v3, v20
    v_dot2_f32_bf16 v20, v114, v4, v20
    v_dot2_f32_bf16 v20, v115, v5, v20
    v_add_f32_dpp v19, v19, v19 row_ror:8 row_mask:0xf bank_mask:0x3
    s_or_b32 s34, s63, 524288
    s_bitcmp1_b32 s64, 4
    s_cbranch_scc0 L_goK14
    s_waitcnt vmcnt(4)
L_goK14:
    s_waitcnt vmcnt(5)
    buffer_load_dwordx4 v[76:79], v1, s[24:27], s34 offen offset:0 nt
    v_dot2_f32_bf16 v21, v116, v2, 0
    v_dot2_f32_bf16 v21, v117, v3, v21
    v_dot2_f32_bf16 v21, v118, v4, v21
    v_dot2_f32_bf16 v21, v119, v5, v21
    v_add_f32_dpp v19, v20, v20 row_ror:8 row_mask:0xf bank_mask:0xc
    s_bitcmp1_b32 s64, 5
    s_cbranch_scc0 L_goK15
    s_waitcnt vmcnt(4)
L_goK15:
    s_waitcnt vmcnt(5)
    buffer_load_dwordx4 v[80:83], v1, s[24:27], s34 offen offset:1024 nt
    v_dot2_f32_bf16 v22, v120, v2, 0
    v_dot2_f32_bf16 v22, v121, v3, v22
    v_dot2_f32_bf16 v22, v122, v4, v22
    v_dot2_f32_bf16 v22, v123, v5, v22
    v_add_f32_dpp v21, v21, v21 row_ror:8 row_mask:0xf bank_mask:0x3
    v_add_f32_dpp v19, v19, v19 row_shl:4 row_mask:0xf bank_mask:0x5
    s_nop 0
    v_add_f32_dpp v21, v22, v22 row_ror:8 row_mask:0xf bank_mask:0xc
    s_nop 1
    v_add_f32_dpp v19, v21, v21 row_shr:4 row_mask:0xf bank_mask:0xa
    s_nop 1
    v_add_f32_dpp v19, v19, v19 quad_perm:[1,0,3,2] row_mask:0xf bank_mask:0xf
    v_cndmask_b32 v18, v18, v19, s[56:57]
    s_nop 1
    v_add_f32_dpp v18, v18, v18 quad_perm:[2,3,0,1] row_mask:0xf bank_mask:0xf
    v_cndmask_b32 v24, v16, v18, s[58:59]
    v_max_f32 v6, v6, v24
    ds_write_b32 v45, v24
    v_add_u32 v45, 256, v45
    s_cmp_lg_u32 s39, 8
    s_cbranch_scc1 L_notag
    s_load_dword s76, s[18:19], 0
L_notag:
    s_cmp_lg_u32 s39, 0
    s_cbranch_scc1 L_loopK
    v_subrev_u32 v45, 4096, v45
    ds_read_b32 v49, v45
    v_max_f32_dpp v6, v6, v6 row_ror:8 row_mask:0xf bank_mask:0xf
    v_mov_b32 v8, 0
    v_mov_b32 v9, 0
    v_max_f32_dpp v6, v6, v6 row_ror:4 row_mask:0xf bank_mask:0xf
    v_mov_b32 v10, 0
    v_mov_b32 v11, 0
    v_max_f32_dpp v6, v6, v6 row_ror:2 row_mask:0xf bank_mask:0xf
    v_mov_b32 v12, 0
    v_mov_b32 v13, 0
    v_max_f32_dpp v6, v6, v6 row_ror:1 row_mask:0xf bank_mask:0xf
    v_mov_b32 v14, 0
    v_mov_b32 v15, 0
    v_mov_b32 v24, v6
    v_mov_b32 v7, 0
    s_nop 0
    v_permlane32_swap_b32 v6, v24
    s_nop 0
    v_max_f32 v6, v6, v24
    v_mov_b32 v24, v6
    s_nop 1
    v_permlane16_swap_b32 v6, v24
    s_nop 0
    v_max_f32 v6, v6, v24
    v_mul_f32 v6, s36, v6
    s_cmp_eq_u32 s77, 0
    s_cbranch_scc1 L_tree
L_loopV:
    s_cbranch_vccz L_loV0
    s_waitcnt vmcnt(3)
L_loV0:
    s_bitcmp1_b32 s64, 6
    s_cbranch_scc0 L_goV0
    s_waitcnt vmcnt(4)
L_goV0:
    s_waitcnt vmcnt(5)
    buffer_load_dwordx4 v[84:87], v1, s[24:27], s34 offen offset:2048 nt
    s_waitcnt lgkmcnt(0)
    v_fma_f32 v50, v49, s36, -v6
    v_add_u32 v45, 256, v45
    v_exp_f32 v50, v50
    ds_read_b32 v49, v45
    v_lshlrev_b32 v28, 16, v60
    v_and_b32 v29, s37, v60
    v_lshlrev_b32 v30, 16, v61
    v_and_b32 v31, s37, v61
    v_mov_b32_dpp v26, v50 row_newbcast:0 row_mask:0xf bank_mask:0xf
    v_lshlrev_b32 v32, 16, v62
    v_and_b32 v33, s37, v62
    v_lshlrev_b32 v34, 16, v63
    v_and_b32 v35, s37, v63
    v_add_f32 v7, v7, v50
    v_pk_fma_f32 v[8:9], v[28:29], v[26:27], v[8:9] op_sel_hi:[1,0,1]
    v_pk_fma_f32 v[10:11], v[30:31], v[26:27], v[10:11] op_sel_hi:[1,0,1]
    v_pk_fma_f32 v[12:13], v[32:33], v[26:27], v[12:13] op_sel_hi:[1,0,1]
    v_pk_fma_f32 v[14:15], v[34:35], v[26:27], v[14:15] op_sel_hi:[1,0,1]
    s_bitcmp1_b32 s64, 7
    s_cbranch_scc0 L_goV1
    s_waitcnt vmcnt(4)
L_goV1:
    s_waitcnt vmcnt(5)
    buffer_load_dwordx4 v[88:91], v1, s[24:27], s34 offen offset:3072 nt
    v_lshlrev_b32 v28, 16, v64
    v_and_b32 v29, s37, v64
    v_lshlrev_b32 v30, 16, v65
    v_and_b32 v31, s37, v65
    v_mov_b32_dpp v26, v50 row_newbcast:8 row_mask:0xf bank_mask:0xf
    v_lshlrev_b32 v32, 16, v66
    v_and_b32 v33, s37, v66
    v_lshlrev_b32 v34, 16, v67
    v_and_b32 v35, s37, v67
    v_pk_fma_f32 v[8:9], v[28:29], v[26:27], v[8:9] op_sel_hi:[1,0,1]
    v_pk_fma_f32 v[10:11], v[30:31], v[26:27], v[10:11] op_sel_hi:[1,0,1]
    v_pk_fma_f32 v[12:13], v[32:33], v[26:27], v[12:13] op_sel_hi:[1,0,1]
    v_pk_fma_f32 v[14:15], v[34:35], v[26:27], v[14:15] op_sel_hi:[1,0,1]
    s_or_b32 s34, s63, 65536
    s_bitcmp1_b32 s64, 8
    s_cbranch_scc0 L_goV2
    s_waitcnt vmcnt(4)
L_goV2:
    s_waitcnt vmcnt(5)
    buffer_load_dwordx4 v[92:95], v1, s[24:27], s34 offen offset:0 nt
    s_cmp_eq_u32 s41, s73
    s_cbranch_scc1 L_glVb
L_glrVb:
    v_lshlrev_b32 v28, 16, v68
    v_and_b32 v29, s37, v68
    v_lshlrev_b32 v30, 16, v69
    v_and_b32 v31, s37, v69
    v_mov_b32_dpp v26, v50 row_newbcast:4 row_mask:0xf bank_mask:0xf
    v_lshlrev_b32 v32, 16, v70
    v_and_b32 v33, s37, v70
    v_lshlrev_b32 v34, 16, v71
    v_and_b32 v35, s37, v71
    v_pk_fma_f32 v[8:9], v[28:29], v[26:27], v[8:9] op_sel_hi:[1,0,1]
    v_pk_fma_f32 v[10:11], v[30:31], v[26:27], v[10:11] op_sel_hi:[1,0,1]
    v_pk_fma_f32 v[12:13], v[32:33], v[26:27], v[12:13] op_sel_hi:[1,0,1]
    v_pk_fma_f32 v[14:15], v[34:35], v[26:27], v[14:15] op_sel_hi:[1,0,1]
    s_cbranch_vccz L_loV3
    s_waitcnt vmcnt(3)
L_loV3:
    s_bitcmp1_b32 s64, 9
    s_cbranch_scc0 L_goV3
    s_waitcnt vmcnt(4)
L_goV3:
    s_waitcnt vmcnt(5)
    buffer_load_dwordx4 v[96:99], v1, s[24:27], s34 offen offset:1024 nt
    v_lshlrev_b32 v28, 16, v72
    v_and_b32 v29, s37, v72
    v_lshlrev_b32 v30, 16, v73
    v_and_b32 v31, s37, v73
    v_mov_b32_dpp v26, v50 row_newbcast:12 row_mask:0xf bank_mask:0xf
    v_lshlrev_b32 v32, 16, v74
    v_and_b32 v33, s37, v74
    v_lshlrev_b32 v34, 16, v75
    v_and_b32 v35, s37, v75
    v_pk_fma_f32 v[8:9], v[28:29], v[26:27], v[8:9] op_sel_hi:[1,0,1]
    v_pk_fma_f32 v[10:11], v[30:31], v[26:27], v[10:11] op_sel_hi:[1,0,1]
    v_pk_fma_f32 v[12:13], v[32:33], v[26:27], v[12:13] op_sel_hi:[1,0,1]
    v_pk_fma_f32 v[14:15], v[34:35], v[26:27], v[14:15] op_sel_hi:[1,0,1]
    s_bitcmp1_b32 s64, 10
    s_cbranch_scc0 L_goV4
    s_waitcnt vmcnt(4)
L_goV4:
    s_waitcnt vmcnt(5)
    buffer_store_byte v48, off, s[68:71], s72 offset:0
    buffer_load_dwordx4 v[100:103], v1, s[24:27], s34 offen offset:2048 nt
    v_lshlrev_b32 v28, 16, v76
    v_and_b32 v29, s37, v76
    v_lshlrev_b32 v30, 16, v77
    v_and_b32 v31, s37, v77
    v_mov_b32_dpp v26, v50 row_newbcast:1 row_mask:0xf bank_mask:0xf
    v_lshlrev_b32 v32, 16, v78
    v_and_b32 v33, s37, v78
    v_lshlrev_b32 v34, 16, v79
    v_and_b32 v35, s37, v79
    v_pk_fma_f32 v[8:9], v[28:29], v[26:27], v[8:9] op_sel_hi:[1,0,1]
    v_pk_fma_f32 v[10:11], v[30:31], v[26:27], v[10:11] op_sel_hi:[1,0,1]
    v_pk_fma_f32 v[12:13], v[32:33], v[26:27], v[12:13] op_sel_hi:[1,0,1]
    v_pk_fma_f32 v[14:15], v[34:35], v[26:27], v[14:15] op_sel_hi:[1,0,1]
    s_bitcmp1_b32 s64, 11
    s_cbranch_scc0 L_goV5
    s_waitcnt vmcnt(5)
L_goV5:
    s_waitcnt vmcnt(6)
    buffer_load_dwordx4 v[104:107], v1, s[24:27], s34 offen offset:3072 nt
    v_lshlrev_b32 v28, 16, v80
    v_and_b32 v29, s37, v80
    v_lshlrev_b32 v30, 16, v81
    v_and_b32 v31, s37, v81
    v_mov_b32_dpp v26, v50 row_newbcast:9 row_mask:0xf bank_mask:0xf
    v_lshlrev_b32 v32, 16, v82
    v_and_b32 v33, s37, v82
    v_lshlrev_b32 v34, 16, v83
    v_and_b32 v35, s37, v83
    v_pk_fma_f32 v[8:9], v[28:29], v[26:27], v[8:9] op_sel_hi:[1,0,1]
    v_pk_fma_f32 v[10:11], v[30:31], v[26:27], v[10:11] op_sel_hi:[1,0,1]
    v_pk_fma_f32 v[12:13], v[32:33], v[26:27], v[12:13] op_sel_hi:[1,0,1]
    v_pk_fma_f32 v[14:15], v[34:35], v[26:27], v[14:15] op_sel_hi:[1,0,1]
    s_or_b32 s34, s63, 589824
    s_cbranch_vccz L_loV6
    s_waitcnt vmcnt(4)
L_loV6:
    s_bitcmp1_b32 s64, 12
    s_cbranch_scc0 L_goV6
    s_waitcnt vmcnt(5)
L_goV6:
    s_waitcnt vmcnt(6)
    buffer_load_ubyte v47, v46, s[68:71], 0 offen
    buffer_load_dwordx4 v[108:111], v1, s[24:27], s34 offen offset:0 nt
    v_lshlrev_b32 v28, 16, v84
    v_and_b32 v29, s37, v84
    v_lshlrev_b32 v30, 16, v85
    v_and_b32 v31, s37, v85
    v_mov_b32_dpp v26, v50 row_newbcast:5 row_mask:0xf bank_mask:0xf
    v_lshlrev_b32 v32, 16, v86
    v_and_b32 v33, s37, v86
    v_lshlrev_b32 v34, 16, v87
    v_and_b32 v35, s37, v87
    v_pk_fma_f32 v[8:9], v[28:29], v[26:27], v[8:9] op_sel_hi:[1,0,1]
    v_pk_fma_f32 v[10:11], v[30:31], v[26:27], v[10:11] op_sel_hi:[1,0,1]
    v_pk_fma_f32 v[12:13], v[32:33], v[26:27], v[12:13] op_sel_hi:[1,0,1]
    v_pk_fma_f32 v[14:15], v[34:35], v[26:27], v[14:15] op_sel_hi:[1,0,1]
    s_bitcmp1_b32 s64, 13
    s_cbranch_scc0 L_goV7
    s_waitcnt vmcnt(6)
L_goV7:
    s_waitcnt vmcnt(7)
    buffer_load_dwordx4 v[112:115], v1, s[24:27], s34 offen offset:1024 nt
    v_lshlrev_b32 v28, 16, v88
    v_and_b32 v29, s37, v88
    v_lshlrev_b32 v30, 16, v89
    v_and_b32 v31, s37, v89
    v_mov_b32_dpp v26, v50 row_newbcast:13 row_mask:0xf bank_mask:0xf
    v_lshlrev_b32 v32, 16, v90
    v_and_b32 v33, s37, v90
    v_lshlrev_b32 v34, 16, v91
    v_and_b32 v35, s37, v91
    v_pk_fma_f32 v[8:9], v[28:29], v[26:27], v[8:9] op_sel_hi:[1,0,1]
    v_pk_fma_f32 v[10:11], v[30:31], v[26:27], v[10:11] op_sel_hi:[1,0,1]
    v_pk_fma_f32 v[12:13], v[32:33], v[26:27], v[12:13] op_sel_hi:[1,0,1]
    v_pk_fma_f32 v[14:15], v[34:35], v[26:27], v[14:15] op_sel_hi:[1,0,1]
    s_bitcmp1_b32 s64, 14
    s_cbranch_scc0 L_goV8
    s_waitcnt vmcnt(6)
L_goV8:
    s_waitcnt vmcnt(7)
    buffer_store_byte v48, off, s[68:71], s72 offset:32
    buffer_load_dwordx4 v[116:119], v1, s[24:27], s34 offen offset:2048 nt
    s_cmp_eq_u32 s40, s73
    s_cbranch_scc1 L_glVa
L_glrVa:
    v_lshlrev_b32 v28, 16, v92
    v_and_b32 v29, s37, v92
    v_lshlrev_b32 v30, 16, v93
    v_and_b32 v31, s37, v93
    v_mov_b32_dpp v26, v50 row_newbcast:2 row_mask:0xf bank_mask:0xf
    v_lshlrev_b32 v32, 16, v94
    v_and_b32 v33, s37, v94
    v_lshlrev_b32 v34, 16, v95
    v_and_b32 v35, s37, v95
    v_pk_fma_f32 v[8:9], v[28:29], v[26:27], v[8:9] op_sel_hi:[1,0,1]
    v_pk_fma_f32 v[10:11], v[30:31], v[26:27], v[10:11] op_sel_hi:[1,0,1]
    v_pk_fma_f32 v[12:13], v[32:33], v[26:27], v[12:13] op_sel_hi:[1,0,1]
    v_pk_fma_f32 v[14:15], v[34:35], v[26:27], v[14:15] op_sel_hi:[1,0,1]
    s_bitcmp1_b32 s64, 15
    s_cbranch_scc0 L_goV9
    s_waitcnt vmcnt(6)
L_goV9:
    s_waitcnt vmcnt(8)
    buffer_load_dwordx4 v[120:123], v1, s[24:27], s34 offen offset:3072 nt
    v_lshlrev_b32 v28, 16, v96
    v_and_b32 v29, s37, v96
    v_lshlrev_b32 v30, 16, v97
    v_and_b32 v31, s37, v97
    v_mov_b32_dpp v26, v50 row_newbcast:10 row_mask:0xf bank_mask:0xf
    v_lshlrev_b32 v32, 16, v98
    v_and_b32 v33, s37, v98
    v_lshlrev_b32 v34, 16, v99
    v_and_b32 v35, s37, v99
    v_pk_fma_f32 v[8:9], v[28:29], v[26:27], v[8:9] op_sel_hi:[1,0,1]
    v_pk_fma_f32 v[10:11], v[30:31], v[26:27], v[10:11] op_sel_hi:[1,0,1]
    v_pk_fma_f32 v[12:13], v[32:33], v[26:27], v[12:13] op_sel_hi:[1,0,1]
    v_pk_fma_f32 v[14:15], v[34:35], v[26:27], v[14:15] op_sel_hi:[1,0,1]
    s_add_u32 s39, s39, 1
    s_ff1_i32_b32 s3, s39
    s_min_u32 s3, s3, 3
    s_lshl_b32 s3, s3, 3
    s_lshr_b32 s3, 0x0c0e1211, s3
    s_lshl_b32 s3, 1, s3
    s_xor_b32 s63, s63, s3
    s_and_b32 s39, s39, 15
    s_cbranch_scc0 L_drain
    s_cbranch_vccz L_loV10
    s_waitcnt vmcnt(4)
L_loV10:
    s_bitcmp1_b32 s64, 0
    s_cbranch_scc0 L_goV10
    s_waitcnt vmcnt(6)
L_goV10:
    s_waitcnt vmcnt(7)
    buffer_load_dwordx4 v[60:63], v1, s[24:27], s63 offen offset:0 nt
    v_lshlrev_b32 v28, 16, v100
    v_and_b32 v29, s37, v100
    v_lshlrev_b32 v30, 16, v101
    v_and_b32 v31, s37, v101
    v_mov_b32_dpp v26, v50 row_newbcast:6 row_mask:0xf bank_mask:0xf
    v_lshlrev_b32 v32, 16, v102
    v_and_b32 v33, s37, v102
    v_lshlrev_b32 v34, 16, v103
    v_and_b32 v35, s37, v103
    v_pk_fma_f32 v[8:9], v[28:29], v[26:27], v[8:9] op_sel_hi:[1,0,1]
    v_pk_fma_f32 v[10:11], v[30:31], v[26:27], v[10:11] op_sel_hi:[1,0,1]
    v_pk_fma_f32 v[12:13], v[32:33], v[26:27], v[12:13] op_sel_hi:[1,0,1]
    v_pk_fma_f32 v[14:15], v[34:35], v[26:27], v[14:15] op_sel_hi:[1,0,1]
    s_bitcmp1_b32 s64, 1
    s_cbranch_scc0 L_goV11
    s_waitcnt vmcnt(5)
L_goV11:
    s_waitcnt vmcnt(7)
    buffer_load_dwordx4 v[64:67], v1, s[24:27], s63 offen offset:1024 nt
    v_lshlrev_b32 v28, 16, v104
    v_and_b32 v29, s37, v104
    v_lshlrev_b32 v30, 16, v105
    v_and_b32 v31, s37, v105
    v_mov_b32_dpp v26, v50 row_newbcast:14 row_mask:0xf bank_mask:0xf
    v_lshlrev_b32 v32, 16, v106
    v_and_b32 v33, s37, v106
    v_lshlrev_b32 v34, 16, v107
    v_and_b32 v35, s37, v107
    v_pk_fma_f32 v[8:9], v[28:29], v[26:27], v[8:9] op_sel_hi:[1,0,1]
    v_pk_fma_f32 v[10:11], v[30:31], v[26:27], v[10:11] op_sel_hi:[1,0,1]
    v_pk_fma_f32 v[12:13], v[32:33], v[26:27], v[12:13] op_sel_hi:[1,0,1]
    v_pk_fma_f32 v[14:15], v[34:35], v[26:27], v[14:15] op_sel_hi:[1,0,1]
    s_bitcmp1_b32 s64, 2
    s_cbranch_scc0 L_goV12
    s_waitcnt vmcnt(5)
L_goV12:
    s_waitcnt vmcnt(6)
    buffer_load_dwordx4 v[68:71], v1, s[24:27], s63 offen offset:2048 nt
    v_cmp_ge_u32 s[74:75], v47, v48
    v_readlane_b32 s43, v47, s72
    v_add_u32 v48, 1, v48
    s_add_u32 s73, s73, 1
    s_bcnt1_i32_b64 s66, s[74:75]
    s_add_u32 s66, s66, s78
    s_add_u32 s66, s66, s43
    s_cmp_ge_u32 s66, 202
    s_cselect_b32 s64, 0x7777, -1
    s_cmp_ge_u32 s66, 214
    s_cselect_b32 s64, 0, s64
    s_cmp_lt_u32 s66, 180
    s_cselect_b64 vcc, -1, 0
    v_lshlrev_b32 v28, 16, v108
    v_and_b32 v29, s37, v108
    v_lshlrev_b32 v30, 16, v109
    v_and_b32 v31, s37, v109
    v_mov_b32_dpp v26, v50 row_newbcast:3 row_mask:0xf bank_mask:0xf
    v_lshlrev_b32 v32, 16, v110
    v_and_b32 v33, s37, v110
    v_lshlrev_b32 v34, 16, v111
    v_and_b32 v35, s37, v111
    v_pk_fma_f32 v[8:9], v[28:29], v[26:27], v[8:9] op_sel_hi:[1,0,1]
    v_pk_fma_f32 v[10:11], v[30:31], v[26:27], v[10:11] op_sel_hi:[1,0,1]
    v_pk_fma_f32 v[12:13], v[32:33], v[26:27], v[12:13] op_sel_hi:[1,0,1]
    v_pk_fma_f32 v[14:15], v[34:35], v[26:27], v[14:15] op_sel_hi:[1,0,1]
    s_cbranch_vccz L_loV13
    s_waitcnt vmcnt(3)
L_loV13:
    s_bitcmp1_b32 s64, 3
    s_cbranch_scc0 L_goV13
    s_waitcnt vmcnt(4)
L_goV13:
    s_waitcnt vmcnt(6)
    buffer_load_dwordx4 v[72:75], v1, s[24:27], s63 offen offset:3072 nt
    s_cmp_eq_u32 s41, s73
    s_cbranch_scc1 L_glVc
L_glrVc:
    v_lshlrev_b32 v28, 16, v112
    v_and_b32 v29, s37, v112
    v_lshlrev_b32 v30, 16, v113
    v_and_b32 v31, s37, v113
    v_mov_b32_dpp v26, v50 row_newbcast:11 row_mask:0xf bank_mask:0xf
    v_lshlrev_b32 v32, 16, v114
    v_and_b32 v33, s37, v114
    v_lshlrev_b32 v34, 16, v115
    v_and_b32 v35, s37, v115
    v_pk_fma_f32 v[8:9], v[28:29], v[26:27], v[8:9] op_sel_hi:[1,0,1]
    v_pk_fma_f32 v[10:11], v[30:31], v[26:27], v[10:11] op_sel_hi:[1,0,1]
    v_pk_fma_f32 v[12:13], v[32:33], v[26:27], v[12:13] op_sel_hi:[1,0,1]
    v_pk_fma_f32 v[14:15], v[34:35], v[26:27], v[14:15] op_sel_hi:[1,0,1]
    s_or_b32 s34, s63, 524288
    s_bitcmp1_b32 s64, 4
    s_cbranch_scc0 L_goV14
    s_waitcnt vmcnt(4)
L_goV14:
    s_waitcnt vmcnt(5)
    buffer_load_dwordx4 v[76:79], v1, s[24:27], s34 offen offset:0 nt
    v_lshlrev_b32 v28, 16, v116
    v_and_b32 v29, s37, v116
    v_lshlrev_b32 v30, 16, v117
    v_and_b32 v31, s37, v117
    v_mov_b32_dpp v26, v50 row_newbcast:7 row_mask:0xf bank_mask:0xf
    v_lshlrev_b32 v32, 16, v118
    v_and_b32 v33, s37, v118
    v_lshlrev_b32 v34, 16, v119
    v_and_b32 v35, s37, v119
    v_pk_fma_f32 v[8:9], v[28:29], v[26:27], v[8:9] op_sel_hi:[1,0,1]
    v_pk_fma_f32 v[10:11], v[30:31], v[26:27], v[10:11] op_sel_hi:[1,0,1]
    v_pk_fma_f32 v[12:13], v[32:33], v[26:27], v[12:13] op_sel_hi:[1,0,1]
    v_pk_fma_f32 v[14:15], v[34:35], v[26:27], v[14:15] op_sel_hi:[1,0,1]
    s_bitcmp1_b32 s64, 5
    s_cbranch_scc0 L_goV15
    s_waitcnt vmcnt(4)
L_goV15:
    s_waitcnt vmcnt(5)
    buffer_load_dwordx4 v[80:83], v1, s[24:27], s34 offen offset:1024 nt
    v_lshlrev_b32 v28, 16, v120
    v_and_b32 v29, s37, v120
    v_lshlrev_b32 v30, 16, v121
    v_and_b32 v31, s37, v121
    v_mov_b32_dpp v26, v50 row_newbcast:15 row_mask:0xf bank_mask:0xf
    v_lshlrev_b32 v32, 16, v122
    v_and_b32 v33, s37, v122
    v_lshlrev_b32 v34, 16, v123
    v_and_b32 v35, s37, v123
    v_pk_fma_f32 v[8:9], v[28:29], v[26:27], v[8:9] op_sel_hi:[1,0,1]
    v_pk_fma_f32 v[10:11], v[30:31], v[26:27], v[10:11] op_sel_hi:[1,0,1]
    v_pk_fma_f32 v[12:13], v[32:33], v[26:27], v[12:13] op_sel_hi:[1,0,1]
    v_pk_fma_f32 v[14:15], v[34:35], v[26:27], v[14:15] op_sel_hi:[1,0,1]
    s_branch L_loopV
L_drain:
    v_add_f32_dpp v7, v7, v7 row_ror:8 row_mask:0xf bank_mask:0xf
    s_nop 1
    v_add_f32_dpp v7, v7, v7 row_ror:4 row_mask:0xf bank_mask:0xf
    s_nop 1
    v_add_f32_dpp v7, v7, v7 row_ror:2 row_mask:0xf bank_mask:0xf
    s_nop 1
    v_add_f32_dpp v7, v7, v7 row_ror:1 row_mask:0xf bank_mask:0xf
    v_mov_b32 v25, v7
    s_nop 1
    v_permlane32_swap_b32 v7, v25
    s_nop 0
    v_add_f32 v7, v7, v25
    v_mov_b32 v25, v7
    v_lshrrev_b32 v24, 7, v53
    v_and_b32 v24, 0x18, v24
    v_permlane16_swap_b32 v7, v25
    v_mov_b32 v51, 0
    v_add_f32 v7, v7, v25
    ds_write_b64 v24, v[6:7] offset:18432
    v_and_b32 v48, s35, v45
    s_waitcnt lgkmcnt(0)
    s_barrier
    global_load_dword v52, v48, s[30:31] nt
    ds_read_b128 v[36:39], v51 offset:18432
    ds_read_b128 v[40:43], v51 offset:18448
    v_lshrrev_b32 v53, 1, v53
    s_waitcnt lgkmcnt(0)
    v_max3_f32 v24, v36, v38, v40
    v_max_f32 v24, v24, v42
    v_sub_f32 v36, v36, v24
    v_sub_f32 v38, v38, v24
    v_sub_f32 v40, v40, v24
    v_sub_f32 v42, v42, v24
    v_sub_f32 v6, v6, v24
    v_exp_f32 v36, v36
    v_exp_f32 v38, v38
    v_exp_f32 v40, v40
    v_exp_f32 v42, v42
    v_exp_f32 v6, v6
    v_mul_f32 v7, v37, v36
    v_fmac_f32 v7, v39, v38
    v_fmac_f32 v7, v41, v40
    v_fmac_f32 v7, v43, v42
    v_rcp_f32 v25, v7
    v_log_f32 v7, v7
    v_mul_f32 v6, v6, v25
    v_add_f32 v18, v7, v24
    v_pk_mul_f32 v[8:9], v[8:9], v[6:7] op_sel_hi:[1,0]
    v_pk_mul_f32 v[10:11], v[10:11], v[6:7] op_sel_hi:[1,0]
    v_pk_mul_f32 v[12:13], v[12:13], v[6:7] op_sel_hi:[1,0]
    v_pk_mul_f32 v[14:15], v[14:15], v[6:7] op_sel_hi:[1,0]
    v_mul_f32 v50, v50, v6
    s_cmp_eq_u32 s76, 0
    s_cbranch_scc1 L_gettag
L_havetag:
    v_mov_b32 v19, s76
    s_mov_b32 s23, 0
    s_waitcnt vmcnt(8)
    v_lshlrev_b32 v28, 16, v100
    v_and_b32 v29, s37, v100
    v_lshlrev_b32 v30, 16, v101
    v_and_b32 v31, s37, v101
    v_mov_b32_dpp v26, v50 row_newbcast:6 row_mask:0xf bank_mask:0xf
    v_lshlrev_b32 v32, 16, v102
    v_and_b32 v33, s37, v102
    v_lshlrev_b32 v34, 16, v103
    v_and_b32 v35, s37, v103
    v_pk_fma_f32 v[8:9], v[28:29], v[26:27], v[8:9] op_sel_hi:[1,0,1]
    v_pk_fma_f32 v[10:11], v[30:31], v[26:27], v[10:11] op_sel_hi:[1,0,1]
    v_pk_fma_f32 v[12:13], v[32:33], v[26:27], v[12:13] op_sel_hi:[1,0,1]
    v_pk_fma_f32 v[14:15], v[34:35], v[26:27], v[14:15] op_sel_hi:[1,0,1]
    s_waitcnt vmcnt(7)
    v_lshlrev_b32 v28, 16, v104
    v_and_b32 v29, s37, v104
    v_lshlrev_b32 v30, 16, v105
    v_and_b32 v31, s37, v105
    v_mov_b32_dpp v26, v50 row_newbcast:14 row_mask:0xf bank_mask:0xf
    v_lshlrev_b32 v32, 16, v106
    v_and_b32 v33, s37, v106
    v_lshlrev_b32 v34, 16, v107
    v_and_b32 v35, s37, v107
    v_pk_fma_f32 v[8:9], v[28:29], v[26:27], v[8:9] op_sel_hi:[1,0,1]
    v_pk_fma_f32 v[10:11], v[30:31], v[26:27], v[10:11] op_sel_hi:[1,0,1]
    v_pk_fma_f32 v[12:13], v[32:33], v[26:27], v[12:13] op_sel_hi:[1,0,1]
    v_pk_fma_f32 v[14:15], v[34:35], v[26:27], v[14:15] op_sel_hi:[1,0,1]
    s_waitcnt vmcnt(5)
    v_lshlrev_b32 v28, 16, v108
    v_and_b32 v29, s37, v108
    v_lshlrev_b32 v30, 16, v109
    v_and_b32 v31, s37, v109
    v_mov_b32_dpp v26, v50 row_newbcast:3 row_mask:0xf bank_mask:0xf
    v_lshlrev_b32 v32, 16, v110
    v_and_b32 v33, s37, v110
    v_lshlrev_b32 v34, 16, v111
    v_and_b32 v35, s37, v111
    v_pk_fma_f32 v[8:9], v[28:29], v[26:27], v[8:9] op_sel_hi:[1,0,1]
    v_pk_fma_f32 v[10:11], v[30:31], v[26:27], v[10:11] op_sel_hi:[1,0,1]
    v_pk_fma_f32 v[12:13], v[32:33], v[26:27], v[12:13] op_sel_hi:[1,0,1]
    v_pk_fma_f32 v[14:15], v[34:35], v[26:27], v[14:15] op_sel_hi:[1,0,1]
    s_waitcnt vmcnt(4)
    v_lshlrev_b32 v28, 16, v112
    v_and_b32 v29, s37, v112
    v_lshlrev_b32 v30, 16, v113
    v_and_b32 v31, s37, v113
    v_mov_b32_dpp v26, v50 row_newbcast:11 row_mask:0xf bank_mask:0xf
    v_lshlrev_b32 v32, 16, v114
    v_and_b32 v33, s37, v114
    v_lshlrev_b32 v34, 16, v115
    v_and_b32 v35, s37, v115
    v_pk_fma_f32 v[8:9], v[28:29], v[26:27], v[8:9] op_sel_hi:[1,0,1]
    v_pk_fma_f32 v[10:11], v[30:31], v[26:27], v[10:11] op_sel_hi:[1,0,1]
    v_pk_fma_f32 v[12:13], v[32:33], v[26:27], v[12:13] op_sel_hi:[1,0,1]
    v_pk_fma_f32 v[14:15], v[34:35], v[26:27], v[14:15] op_sel_hi:[1,0,1]
    s_waitcnt vmcnt(2)
    v_lshlrev_b32 v28, 16, v116
    v_and_b32 v29, s37, v116
    v_lshlrev_b32 v30, 16, v117
    v_and_b32 v31, s37, v117
    v_mov_b32_dpp v26, v50 row_newbcast:7 row_mask:0xf bank_mask:0xf
    v_lshlrev_b32 v32, 16, v118
    v_and_b32 v33, s37, v118
    v_lshlrev_b32 v34, 16, v119
    v_and_b32 v35, s37, v119
    v_pk_fma_f32 v[8:9], v[28:29], v[26:27], v[8:9] op_sel_hi:[1,0,1]
    v_pk_fma_f32 v[10:11], v[30:31], v[26:27], v[10:11] op_sel_hi:[1,0,1]
    v_pk_fma_f32 v[12:13], v[32:33], v[26:27], v[12:13] op_sel_hi:[1,0,1]
    v_pk_fma_f32 v[14:15], v[34:35], v[26:27], v[14:15] op_sel_hi:[1,0,1]
    s_waitcnt vmcnt(1)
    v_lshlrev_b32 v28, 16, v120
    v_and_b32 v29, s37, v120
    v_lshlrev_b32 v30, 16, v121
    v_and_b32 v31, s37, v121
    v_mov_b32_dpp v26, v50 row_newbcast:15 row_mask:0xf bank_mask:0xf
    v_lshlrev_b32 v32, 16, v122
    v_and_b32 v33, s37, v122
    v_lshlrev_b32 v34, 16, v123
    v_and_b32 v35, s37, v123
    v_pk_fma_f32 v[8:9], v[28:29], v[26:27], v[8:9] op_sel_hi:[1,0,1]
    v_pk_fma_f32 v[10:11], v[30:31], v[26:27], v[10:11] op_sel_hi:[1,0,1]
    v_pk_fma_f32 v[12:13], v[32:33], v[26:27], v[12:13] op_sel_hi:[1,0,1]
    v_pk_fma_f32 v[14:15], v[34:35], v[26:27], v[14:15] op_sel_hi:[1,0,1]
    s_cmp_eq_u32 s38, 0
    v_permlane32_swap_b32 v8, v12
    v_permlane32_swap_b32 v9, v13
    v_permlane32_swap_b32 v10, v14
    v_permlane32_swap_b32 v11, v15
    v_pk_add_f32 v[8:9], v[8:9], v[12:13]
    v_pk_add_f32 v[10:11], v[10:11], v[14:15]
    s_nop 1
    v_permlane16_swap_b32 v8, v10
    v_permlane16_swap_b32 v9, v11
    s_nop 0
    v_pk_add_f32 v[16:17], v[8:9], v[10:11]
    s_cbranch_scc1 L_w0
    ds_write_b64 v53, v[16:17] offset:16384
    s_waitcnt lgkmcnt(0)
    s_barrier
    s_endpgm
L_w0:
    s_cmp_eq_u32 s33, 0
    s_cbranch_scc1 L_cons
    s_barrier
    ds_read_b64 v[94:95], v53 offset:16896
    ds_read_b64 v[96:97], v53 offset:17408
    ds_read_b64 v[98:99], v53 offset:17920
    s_waitcnt lgkmcnt(2)
    v_pk_add_f32 v[16:17], v[16:17], v[94:95]
    s_waitcnt lgkmcnt(0)
    v_pk_add_f32 v[96:97], v[96:97], v[98:99]
    v_pk_add_f32 v[16:17], v[16:17], v[96:97]
    global_store_dwordx4 v54, v[16:19], s[20:21]
    global_store_dwordx4 v55, v[16:19], s[20:21] sc0 sc1
    s_endpgm
L_again:
    s_add_u32 s23, s23, 1
    s_cmp_ge_u32 s23, 20
    s_cbranch_scc1 L_far
    global_load_dwordx4 v[108:111], v54, s[20:21] offset:1024 sc1
    global_load_dwordx4 v[112:115], v54, s[20:21] offset:2048 sc1
    global_load_dwordx4 v[116:119], v54, s[20:21] offset:3072 sc1
    s_branch L_chk
L_cons:
    global_load_dwordx4 v[108:111], v54, s[20:21] offset:1024 sc1
    global_load_dwordx4 v[112:115], v54, s[20:21] offset:2048 sc1
    global_load_dwordx4 v[116:119], v54, s[20:21] offset:3072 sc1
    s_barrier
    ds_read_b64 v[94:95], v53 offset:16896
    ds_read_b64 v[96:97], v53 offset:17408
    ds_read_b64 v[98:99], v53 offset:17920
    s_waitcnt lgkmcnt(2)
    v_pk_add_f32 v[16:17], v[16:17], v[94:95]
    s_waitcnt lgkmcnt(0)
    v_pk_add_f32 v[96:97], v[96:97], v[98:99]
    v_pk_add_f32 v[16:17], v[16:17], v[96:97]
L_chk:
    s_waitcnt vmcnt(0)
    v_cmp_eq_u32 vcc, s76, v111
    v_cmp_eq_u32 s[56:57], s76, v115
    v_cmp_eq_u32 s[58:59], s76, v119
    v_max3_f32 v6, v110, v114, v118
    s_and_b64 vcc, vcc, s[56:57]
    s_and_b64 vcc, vcc, s[58:59]
    v_max_f32 v6, v6, v18
    s_cmp_eq_u64 vcc, -1
    s_cbranch_scc0 L_again
    v_sub_f32 v24, v18, v6
    v_sub_f32 v110, v110, v6
    v_sub_f32 v114, v114, v6
    v_sub_f32 v118, v118, v6
    v_exp_f32 v24, v24
    v_exp_f32 v110, v110
    v_exp_f32 v114, v114
    v_exp_f32 v118, v118
    v_add_f32 v7, v24, v110
    v_pk_mul_f32 v[16:17], v[16:17], v[24:25] op_sel_hi:[1,0]
    v_add_f32 v7, v7, v114
    v_add_f32 v7, v7, v118
    v_rcp_f32 v24, v7
    v_pk_fma_f32 v[16:17], v[108:109], v[110:111], v[16:17] op_sel_hi:[1,0,1]
    v_pk_fma_f32 v[16:17], v[112:113], v[114:115], v[16:17] op_sel_hi:[1,0,1]
    v_pk_fma_f32 v[16:17], v[116:117], v[118:119], v[16:17] op_sel_hi:[1,0,1]
    v_pk_mul_f32 v[16:17], v[16:17], v[24:25] op_sel_hi:[1,0]
    v_cvt_pk_bf16_f32 v16, v16, v17
    global_store_dword v56, v16, s[16:17]
L_end:
    s_endpgm
L_far:
    s_cmp_ge_u32 s23, 4194304
    s_cbranch_scc1 L_end
    global_load_dwordx4 v[108:111], v55, s[20:21] offset:1024 sc0 sc1
    global_load_dwordx4 v[112:115], v55, s[20:21] offset:2048 sc0 sc1
    global_load_dwordx4 v[116:119], v55, s[20:21] offset:3072 sc0 sc1
    s_branch L_chk
L_glKa:
    s_mov_b32 s42, 1
    s_atomic_add s42, s[20:21], s50 glc
    s_branch L_glrKa
L_glKc:
    s_load_dword s51, s[20:21], s50 glc
    s_branch L_glrKc
L_glKb:
    s_waitcnt lgkmcnt(0)
    s_min_u32 s3, s42, 7
    s_mul_i32 s3, s3, 24
    s_mul_i32 s23, s43, 8
    s_add_u32 s3, s3, s23
    s_min_u32 s23, s51, 8
    s_mul_i32 s23, s23, 40
    s_add_u32 s3, s3, s23
    s_add_u32 s3, s3, 884
    s_lshr_b32 s3, s3, 4
    v_mov_b32 v51, s3
    buffer_store_byte v51, off, s[68:71], 0 offset:64
    s_branch L_glrKb
L_glVa:
    s_mov_b32 s42, 1
    s_atomic_add s42, s[20:21], s50 glc
    s_branch L_glrVa
L_glVc:
    s_load_dword s51, s[20:21], s50 glc
    s_branch L_glrVc
L_glVb:
    s_waitcnt lgkmcnt(0)
    s_min_u32 s3, s42, 7
    s_mul_i32 s3, s3, 24
    s_mul_i32 s23, s43, 8
    s_add_u32 s3, s3, s23
    s_min_u32 s23, s51, 8
    s_mul_i32 s23, s23, 40
    s_add_u32 s3, s3, s23
    s_add_u32 s3, s3, 884
    s_lshr_b32 s3, s3, 4
    v_mov_b32 v51, s3
    buffer_store_byte v51, off, s[68:71], 0 offset:64
    s_branch L_glrVb
L_tree:
    v_dot2_f32_bf16 v24, v36, v2, 0
    v_dot2_f32_bf16 v24, v37, v3, v24
    v_dot2_f32_bf16 v24, v38, v4, v24
    v_dot2_f32_bf16 v24, v39, v5, v24
    v_lshlrev_b32 v44, 16, v44
    v_sub_f32 v44, 1.0, v44
    v_mul_f32 v44, 0xceabfb8f, v44
    v_add_f32_dpp v24, v24, v24 row_ror:8 row_mask:0xf bank_mask:0xf
    v_lshlrev_b32 v28, 16, v40
    v_and_b32 v29, s37, v40
    v_add_f32_dpp v24, v24, v24 row_ror:4 row_mask:0xf bank_mask:0xf
    v_lshlrev_b32 v30, 16, v41
    v_and_b32 v31, s37, v41
    v_add_f32_dpp v24, v24, v24 row_ror:2 row_mask:0xf bank_mask:0xf
    v_lshlrev_b32 v32, 16, v42
    v_and_b32 v33, s37, v42
    v_add_f32_dpp v24, v24, v24 row_ror:1 row_mask:0xf bank_mask:0xf
    v_lshlrev_b32 v34, 16, v43
    v_and_b32 v35, s37, v43
    v_fma_f32 v24, v24, s36, v44
    v_max_f32 v6, v6, v24
    v_sub_f32 v24, v24, v6
    v_exp_f32 v24, v24
    s_mov_b64 exec, 0xffff
    v_pk_mul_f32 v[8:9], v[28:29], v[24:25] op_sel_hi:[1,0]
    v_pk_mul_f32 v[10:11], v[30:31], v[24:25] op_sel_hi:[1,0]
    v_pk_mul_f32 v[12:13], v[32:33], v[24:25] op_sel_hi:[1,0]
    v_pk_mul_f32 v[14:15], v[34:35], v[24:25] op_sel_hi:[1,0]
    s_mov_b64 exec, 1
    v_mov_b32 v7, v24
    s_mov_b64 exec, -1
    s_branch L_loopV
L_mktag:
    v_and_b32 v25, 63, v0
    v_mul_u32_u24 v24, 4480, v25
    v_add_u32 v24, 786432, v24
    v_lshlrev_b32 v25, 12, v25
    v_add_u32 v26, 262144, v25
    s_mov_b64 exec, 0x15555554
    global_store_dword v24, v51, s[20:21] sc0 sc1
    s_mov_b64 exec, -1
    global_load_dword v28, v25, s[20:21] offset:1036 sc0 sc1 nt
    global_load_dword v29, v25, s[20:21] offset:2060 sc0 sc1 nt
    global_load_dword v30, v25, s[20:21] offset:3084 sc0 sc1 nt
    global_load_dword v31, v26, s[20:21] offset:1036 sc0 sc1 nt
    global_load_dword v32, v26, s[20:21] offset:2060 sc0 sc1 nt
    global_load_dword v33, v26, s[20:21] offset:3084 sc0 sc1 nt
    s_waitcnt vmcnt(0)
    v_readfirstlane_b32 s3, v28
    s_nop 1
L_mktag2:
    s_mul_i32 s3, s3, 0x2c9277b5
    s_add_u32 s3, s3, 0xac564b05
    v_cmp_eq_u32 vcc, s3, v51
    v_cmp_eq_u32 s[74:75], s3, v28
    s_or_b64 vcc, vcc, s[74:75]
    v_cmp_eq_u32 s[74:75], s3, v29
    s_or_b64 vcc, vcc, s[74:75]
    v_cmp_eq_u32 s[74:75], s3, v30
    s_or_b64 vcc, vcc, s[74:75]
    v_cmp_eq_u32 s[74:75], s3, v31
    s_or_b64 vcc, vcc, s[74:75]
    v_cmp_eq_u32 s[74:75], s3, v32
    s_or_b64 vcc, vcc, s[74:75]
    v_cmp_eq_u32 s[74:75], s3, v33
    s_or_b64 vcc, vcc, s[74:75]
    s_cbranch_scc1 L_mktag2
    v_mov_b32 v26, s3
    s_mov_b64 exec, 1
    global_store_dword v51, v26, s[18:19] sc0 sc1
    s_mov_b64 exec, -1
    s_branch L_loopK
L_gettag:
    s_mov_b32 s23, 0
L_gettag2:
    s_add_u32 s23, s23, 1
    s_cmp_ge_u32 s23, 4194304
    s_cbranch_scc1 L_end
    global_load_dword v25, v51, s[18:19] sc0 sc1
    s_waitcnt vmcnt(0)
    v_readfirstlane_b32 s76, v25
    s_nop 1
    s_cmp_lg_u32 s76, 0
    s_cbranch_scc1 L_havetag
L_last:
    s_branch L_gettag2
.section .rodata,"a"
.p2align 6
.amdhsa_kernel standalone__tree_speculative_verify_tree_attention_over_candidate_token_tree__decode_kernel
  .amdhsa_next_free_vgpr 124
  .amdhsa_next_free_sgpr 80
  .amdhsa_accum_offset 124
  .amdhsa_group_segment_fixed_size 0
  .amdhsa_kernarg_size 72
  .amdhsa_user_sgpr_count 2
  .amdhsa_user_sgpr_kernarg_segment_ptr 1
  .amdhsa_system_sgpr_workgroup_id_x 1
.end_amdhsa_kernel
```
